```python
import torch

def _softmax(x, axis=-1):
    return torch.softmax(x, dim=axis)
def _gelu(x):
    return torch.nn.functional.gelu(x, approximate="tanh")
def _silu(x):
    return torch.nn.functional.silu(x)
def _sigmoid(x):
    return torch.sigmoid(x)
def _layernorm(x, axis=-1, eps=1e-5):
    m = x.mean(dim=axis, keepdim=True)
    v = x.var(dim=axis, keepdim=True, unbiased=False)
    return (x - m) / torch.sqrt(v + eps)
def _scatter_add(tgt, idx, src, axis=0):
    return tgt.clone().index_add_(axis, idx, src)
def _segment_sum(src, seg, n):
    out = torch.zeros((n,) + src.shape[1:], dtype=src.dtype)
    return out.index_add_(0, seg, src)
def _pad(x, pw):
    flat = tuple(v for pair in reversed(pw) for v in pair)
    return torch.nn.functional.pad(x, flat)

kernel_name = 'recurrent_scan__sliding_block_cached__swiglu_ffn__decode'

def setup_inputs():

    _w = (lambda a: (lambda t: t.to(torch.bfloat16) if t.is_floating_point() else t)(torch.as_tensor(a)))
    def _A_setup():
        B, Sq, D = 1, 1, 512
        Hq, Hkv, Sk, Dh = 32, 8, 65536, 128
        assert Hq % Hkv == 0, (Hq, Hkv)
        return {
            "x": _w((lambda *s: torch.randn(*s, dtype=torch.bfloat16) * 0.05)(B, Sq, D)),
            "k_cache": _w((lambda *s: torch.randn(*s, dtype=torch.bfloat16) * 1.6)(B, Hkv, Sk, Dh)),
            "v_cache": _w((lambda *s: torch.randn(*s, dtype=torch.bfloat16) * 0.2)(B, Hkv, Sk, Dh)),
            "wq": _w((lambda *s: torch.randn(*s, dtype=torch.bfloat16) * 1.6)(D, Hq * Dh) * (D ** -0.5)),
            "wo": _w((lambda *s: torch.randn(*s, dtype=torch.bfloat16) * 0.2)(Hq * Dh, D) * ((Hq * Dh) ** -0.5)),
        }
    _A_in = _A_setup()

    def _B_setup():
        B, S, D, F = 1, 1, 512, 1792
        return {
            "x": _w((lambda *s: torch.randn(*s, dtype=torch.bfloat16) * 0.05)(B, S, D)),
            "w_gate": _w((lambda *s: torch.randn(*s, dtype=torch.bfloat16) * 0.1)(D, F)),
            "w_up": _w((lambda *s: torch.randn(*s, dtype=torch.bfloat16) * 0.1)(D, F)),
            "w_down": _w((lambda *s: torch.randn(*s, dtype=torch.bfloat16) * 0.1)(F, D)),
        }
    _B_in = _B_setup()

    return {
        "A_x": _A_in["x"],
        "A_k_cache": _A_in["k_cache"],
        "A_v_cache": _A_in["v_cache"],
        "A_wq": _A_in["wq"],
        "A_wo": _A_in["wo"],
        "B_x": _B_in["x"],
        "B_w_gate": _B_in["w_gate"],
        "B_w_up": _B_in["w_up"],
        "B_w_down": _B_in["w_down"],
    }

def reference(A_x, A_k_cache, A_v_cache, A_wq, A_wo, B_x, B_w_gate, B_w_up, B_w_down):
    def _A_ref(x, k_cache, v_cache, wq, wo):
        B, Sq, D = x.shape
        Hq, Dh = 32, 128
        Hkv, Sk = k_cache.shape[1], k_cache.shape[2]
        W = min(4096, max(256, Sk // 4))
        rep = Hq // Hkv
        q = (lambda x, *d: x.permute(*d))((x @ wq).reshape(B, Sq, Hq, Dh), 0, 2, 1, 3)
        k = (lambda x, n, axis: torch.repeat_interleave(x, n, dim=axis))(k_cache[:, :, Sk - W:, :], rep, axis=1)
        v = (lambda x, n, axis: torch.repeat_interleave(x, n, dim=axis))(v_cache[:, :, Sk - W:, :], rep, axis=1)
        scores = torch.einsum("bhqd,bhkd->bhqk", q, k) * (Dh ** -0.5)
        p = _softmax(scores, axis=-1)
        o = torch.einsum("bhqk,bhkd->bhqd", p, v)
        return (lambda x, *d: x.permute(*d))(o, 0, 2, 1, 3).reshape(B, Sq, Hq * Dh) @ wo

    def _B_ref(x, w_gate, w_up, w_down):
        g = _silu(x @ w_gate)
        u = x @ w_up
        return (g * u) @ w_down

    x = A_x
    xn = _layernorm(x, axis=-1)
    s = _A_ref(xn, A_k_cache, A_v_cache, A_wq, A_wo)
    g = _silu(_B_ref(xn, B_w_gate, B_w_up, B_w_down))
    return x + s * g
```

```asm
; @launch grid=(256,1,1) block=(576,1,1) lds=134080
.amdgcn_target "amdgcn-amd-amdhsa--gfx950"
.text
.globl recurrent_scan__sliding_block_cached__swiglu_ffn__decode_kernel
.p2align 8
.type recurrent_scan__sliding_block_cached__swiglu_ffn__decode_kernel,@function
recurrent_scan__sliding_block_cached__swiglu_ffn__decode_kernel:
    s_load_dwordx2 s[32:33], s[0:1], 24
    s_load_dwordx16 s[4:19], s[0:1], 0
    s_load_dwordx8 s[20:27], s[0:1], 64
    s_getpc_b64 s[30:31]
L_pc:
    v_lshrrev_b32 v1, 2, v0
    v_min_u32 v1, (L_codeend-L_pc-4)>>7, v1
    v_lshlrev_b32 v1, 7, v1
    s_cmp_ge_u32 s2, 256
    s_cbranch_scc1 L_end
    global_load_dword v23, v1, s[30:31]
    v_readfirstlane_b32 s3, v0
    v_lshlrev_b32 v3, 4, v0
    s_and_b32 s28, s2, 7
    s_lshr_b32 s29, s2, 3
    s_cmp_eq_u32 s3, 64
    s_cbranch_scc0 L_notx
    s_waitcnt lgkmcnt(0)
    global_load_dwordx4 v[24:27], v3, s[4:5] offset:-1024
L_notx:
    s_cmp_ge_u32 s3, 64
    s_cbranch_scc1 L_compute
    s_setprio 3
    v_lshrrev_b32 v2, 3, v0
    v_lshlrev_b32 v1, 1, v0
    v_and_b32 v1, 32, v1
    v_and_b32 v4, 0x70, v3
    v_xor_b32 v1, v1, v4
    v_lshl_add_u32 v10, v2, 13, v1
    v_xor_b32 v11, 64, v10
    v_add_u32 v11, 0xfc00, v11
    s_mov_b32 s34, 0x400000
    s_mov_b32 s35, 0x20000
    s_lshr_b32 s60, s29, 3
    s_lshl_b32 s60, s60, 10
    s_add_u32 s60, s60, s28
    s_lshl_b32 s60, s60, 3
    s_and_b32 s61, s29, 7
    s_add_u32 s60, s60, s61
    s_lshl_b32 s60, s60, 7
    s_mov_b32 m0, 0
    s_waitcnt lgkmcnt(0)
L_wq:
    buffer_load_dwordx4 v10, s[32:35], s60 offen offset:0 nt lds
    buffer_load_dwordx4 v11, s[32:35], s60 offen offset:1024 nt lds
    s_addk_i32 m0, 0x800
    s_add_u32 s60, s60, s35
    s_bitcmp0_b32 m0, 14
    s_cbranch_scc1 L_wq
    s_cmp_eq_u32 s28, 0
    s_cbranch_scc1 L_light
    s_mov_b64 s[36:37], s[16:17]
    s_mov_b32 s38, 0x1c0000
    s_mov_b32 s39, 0x20000
    v_mul_u32_u24 v12, 3584, v2
    v_add_u32 v12, v12, v1
    v_xor_b32 v13, 64, v12
    s_lshr_b32 s60, s29, 2
    s_mul_i32 s60, s60, 229376
    s_lshl_b32 s62, s28, 2
    s_and_b32 s63, s29, 3
    s_add_u32 s62, s62, s63
    s_sub_u32 s62, s62, 4
    s_lshl_b32 s62, s62, 7
    s_add_u32 s60, s60, s62
    s_mov_b32 m0, 16384
    s_nop 0
    buffer_load_dwordx4 v12, s[36:39], s60 offen offset:0 nt lds
    s_add_u32 s61, s60, 27648
    buffer_load_dwordx4 v13, s[36:39], s61 offen offset:1024 nt lds
    s_add_u32 s61, s60, 55296
    buffer_load_dwordx4 v12, s[36:39], s61 offen offset:2048 nt lds
    s_add_u32 s61, s60, 82944
    buffer_load_dwordx4 v13, s[36:39], s61 offen offset:3072 nt lds
    s_mov_b32 m0, 20480
    s_add_u32 s61, s60, 114688
    buffer_load_dwordx4 v12, s[36:39], s61 offen offset:0 nt lds
    s_add_u32 s61, s60, 142336
    buffer_load_dwordx4 v13, s[36:39], s61 offen offset:1024 nt lds
    s_add_u32 s61, s60, 169984
    buffer_load_dwordx4 v12, s[36:39], s61 offen offset:2048 nt lds
    s_add_u32 s61, s60, 197632
    buffer_load_dwordx4 v13, s[36:39], s61 offen offset:3072 nt lds
    s_mov_b64 s[40:41], s[18:19]
    s_mov_b32 s42, 0x1c0000
    s_mov_b32 s43, 0x20000
    s_mov_b32 m0, 24576
    s_waitcnt vmcnt(23)
    buffer_load_dwordx4 v12, s[40:43], s60 offen offset:0 nt lds
    s_add_u32 s61, s60, 27648
    s_waitcnt vmcnt(23)
    buffer_load_dwordx4 v13, s[40:43], s61 offen offset:1024 nt lds
    s_add_u32 s61, s60, 55296
    s_waitcnt vmcnt(23)
    buffer_load_dwordx4 v12, s[40:43], s61 offen offset:2048 nt lds
    s_add_u32 s61, s60, 82944
    s_waitcnt vmcnt(23)
    buffer_load_dwordx4 v13, s[40:43], s61 offen offset:3072 nt lds
    s_mov_b32 m0, 28672
    s_add_u32 s61, s60, 114688
    s_waitcnt vmcnt(23)
    buffer_load_dwordx4 v12, s[40:43], s61 offen offset:0 nt lds
    s_add_u32 s61, s60, 142336
    s_waitcnt vmcnt(23)
    buffer_load_dwordx4 v13, s[40:43], s61 offen offset:1024 nt lds
    s_add_u32 s61, s60, 169984
    s_waitcnt vmcnt(23)
    buffer_load_dwordx4 v12, s[40:43], s61 offen offset:2048 nt lds
    s_add_u32 s61, s60, 197632
    s_waitcnt vmcnt(23)
    buffer_load_dwordx4 v13, s[40:43], s61 offen offset:3072 nt lds
    s_mov_b64 s[44:45], s[6:7]
    s_mov_b32 s46, 0x8000000
    s_mov_b32 s47, 0x20000
    s_lshl_b32 s60, s28, 24
    s_lshl_b32 s62, s29, 10
    s_add_u32 s60, s60, s62
    s_add_u32 s60, s60, 15728640
    v_lshrrev_b32 v5, 4, v0
    v_and_b32 v6, 0xf0, v3
    v_lshlrev_b32 v7, 4, v5
    v_xor_b32 v14, v6, v7
    v_lshl_add_u32 v14, v5, 8, v14
    v_xor_b32 v15, 64, v14
    v_xor_b32 v16, 128, v14
    v_xor_b32 v17, 192, v14
    s_mov_b32 m0, 32768
    s_waitcnt vmcnt(23)
    buffer_load_dwordx4 v14, s[44:47], s60 offen offset:0 nt lds
    s_add_u32 s61, s60, 31744
    s_waitcnt vmcnt(23)
    buffer_load_dwordx4 v15, s[44:47], s61 offen offset:1024 nt lds
    s_addk_i32 s61, 31744
    s_waitcnt vmcnt(23)
    buffer_load_dwordx4 v16, s[44:47], s61 offen offset:2048 nt lds
    s_addk_i32 s61, 31744
    s_waitcnt vmcnt(23)
    buffer_load_dwordx4 v17, s[44:47], s61 offen offset:3072 nt lds
    s_mov_b32 m0, 36864
    s_xor_b32 s61, s60, 0x21000
    s_waitcnt vmcnt(23)
    buffer_load_dwordx4 v14, s[44:47], s61 offen offset:0 nt lds
    s_addk_i32 s61, 31744
    s_waitcnt vmcnt(23)
    buffer_load_dwordx4 v15, s[44:47], s61 offen offset:1024 nt lds
    s_addk_i32 s61, 31744
    s_waitcnt vmcnt(23)
    buffer_load_dwordx4 v16, s[44:47], s61 offen offset:2048 nt lds
    s_addk_i32 s61, 31744
    s_waitcnt vmcnt(23)
    s_barrier
    buffer_load_dwordx4 v17, s[44:47], s61 offen offset:3072 nt lds
    s_mov_b32 m0, 40960
    s_xor_b32 s61, s60, 0x42000
    s_waitcnt vmcnt(23)
    buffer_load_dwordx4 v14, s[44:47], s61 offen offset:0 nt lds
    s_addk_i32 s61, 31744
    s_waitcnt vmcnt(23)
    buffer_load_dwordx4 v15, s[44:47], s61 offen offset:1024 nt lds
    s_addk_i32 s61, 31744
    s_waitcnt vmcnt(23)
    buffer_load_dwordx4 v16, s[44:47], s61 offen offset:2048 nt lds
    s_addk_i32 s61, 31744
    s_waitcnt vmcnt(23)
    buffer_load_dwordx4 v17, s[44:47], s61 offen offset:3072 nt lds
    s_mov_b32 m0, 45056
    s_xor_b32 s61, s60, 0x63000
    s_waitcnt vmcnt(23)
    buffer_load_dwordx4 v14, s[44:47], s61 offen offset:0 nt lds
    s_addk_i32 s61, 31744
    s_waitcnt vmcnt(23)
    buffer_load_dwordx4 v15, s[44:47], s61 offen offset:1024 nt lds
    s_addk_i32 s61, 31744
    s_waitcnt vmcnt(23)
    buffer_load_dwordx4 v16, s[44:47], s61 offen offset:2048 nt lds
    s_addk_i32 s61, 31744
    s_waitcnt vmcnt(23)
    buffer_load_dwordx4 v17, s[44:47], s61 offen offset:3072 nt lds
    s_mov_b32 m0, 49152
    s_xor_b32 s61, s60, 0x84000
    s_waitcnt vmcnt(23)
    buffer_load_dwordx4 v14, s[44:47], s61 offen offset:0 nt lds
    s_addk_i32 s61, 31744
    s_waitcnt vmcnt(23)
    buffer_load_dwordx4 v15, s[44:47], s61 offen offset:1024 nt lds
    s_addk_i32 s61, 31744
    s_waitcnt vmcnt(23)
    buffer_load_dwordx4 v16, s[44:47], s61 offen offset:2048 nt lds
    s_addk_i32 s61, 31744
    s_waitcnt vmcnt(23)
    buffer_load_dwordx4 v17, s[44:47], s61 offen offset:3072 nt lds
    s_mov_b32 m0, 53248
    s_xor_b32 s61, s60, 0xa5000
    s_waitcnt vmcnt(23)
    buffer_load_dwordx4 v14, s[44:47], s61 offen offset:0 nt lds
    s_addk_i32 s61, 31744
    s_waitcnt vmcnt(23)
    buffer_load_dwordx4 v15, s[44:47], s61 offen offset:1024 nt lds
    s_addk_i32 s61, 31744
    s_waitcnt vmcnt(23)
    buffer_load_dwordx4 v16, s[44:47], s61 offen offset:2048 nt lds
    s_addk_i32 s61, 31744
    s_waitcnt vmcnt(23)
    s_barrier
    buffer_load_dwordx4 v17, s[44:47], s61 offen offset:3072 nt lds
    s_mov_b32 m0, 57344
    s_xor_b32 s61, s60, 0xc6000
    s_waitcnt vmcnt(23)
    buffer_load_dwordx4 v14, s[44:47], s61 offen offset:0 nt lds
    s_addk_i32 s61, 31744
    s_waitcnt vmcnt(23)
    buffer_load_dwordx4 v15, s[44:47], s61 offen offset:1024 nt lds
    s_addk_i32 s61, 31744
    s_waitcnt vmcnt(23)
    buffer_load_dwordx4 v16, s[44:47], s61 offen offset:2048 nt lds
    s_addk_i32 s61, 31744
    s_waitcnt vmcnt(23)
    buffer_load_dwordx4 v17, s[44:47], s61 offen offset:3072 nt lds
    s_mov_b32 m0, 61440
    s_xor_b32 s61, s60, 0xe7000
    s_waitcnt vmcnt(23)
    buffer_load_dwordx4 v14, s[44:47], s61 offen offset:0 nt lds
    s_addk_i32 s61, 31744
    s_waitcnt vmcnt(23)
    buffer_load_dwordx4 v15, s[44:47], s61 offen offset:1024 nt lds
    s_addk_i32 s61, 31744
    s_waitcnt vmcnt(23)
    buffer_load_dwordx4 v16, s[44:47], s61 offen offset:2048 nt lds
    s_addk_i32 s61, 31744
    s_waitcnt vmcnt(23)
    buffer_load_dwordx4 v17, s[44:47], s61 offen offset:3072 nt lds
    s_mov_b64 s[48:49], s[8:9]
    s_mov_b32 s50, 0x8000000
    s_mov_b32 s51, 0x20000
    s_lshl_b32 s60, s28, 24
    s_lshl_b32 s62, s29, 10
    s_add_u32 s60, s60, s62
    s_add_u32 s60, s60, 15728640
    v_lshrrev_b32 v5, 4, v0
    v_and_b32 v6, 0xf0, v3
    v_lshlrev_b32 v7, 5, v5
    v_xor_b32 v6, v6, v7
    v_lshl_add_u32 v18, v5, 8, v6
    v_xor_b32 v19, 128, v18
    v_lshl_add_u32 v20, v5, 10, v6
    v_xor_b32 v21, 128, v20
    s_mov_b32 m0, 65536
    s_waitcnt vmcnt(23)
    buffer_load_dwordx4 v18, s[48:51], s60 offen offset:0 nt lds
    s_add_u32 s61, s60, 31744
    s_waitcnt vmcnt(23)
    buffer_load_dwordx4 v18, s[48:51], s61 offen offset:1024 nt lds
    s_addk_i32 s61, 31744
    s_waitcnt vmcnt(23)
    buffer_load_dwordx4 v19, s[48:51], s61 offen offset:2048 nt lds
    s_addk_i32 s61, 31744
    s_waitcnt vmcnt(23)
    buffer_load_dwordx4 v19, s[48:51], s61 offen offset:3072 nt lds
    s_mov_b32 m0, 69632
    s_xor_b32 s61, s60, 0x21000
    s_waitcnt vmcnt(23)
    buffer_load_dwordx4 v18, s[48:51], s61 offen offset:0 nt lds
    s_addk_i32 s61, 31744
    s_waitcnt vmcnt(23)
    buffer_load_dwordx4 v18, s[48:51], s61 offen offset:1024 nt lds
    s_addk_i32 s61, 31744
    s_waitcnt vmcnt(23)
    buffer_load_dwordx4 v19, s[48:51], s61 offen offset:2048 nt lds
    s_addk_i32 s61, 31744
    s_waitcnt vmcnt(23)
    s_barrier
    buffer_load_dwordx4 v19, s[48:51], s61 offen offset:3072 nt lds
    s_mov_b32 m0, 73728
    s_xor_b32 s61, s60, 0x42000
    s_waitcnt vmcnt(23)
    buffer_load_dwordx4 v18, s[48:51], s61 offen offset:0 nt lds
    s_addk_i32 s61, 31744
    s_waitcnt vmcnt(23)
    buffer_load_dwordx4 v18, s[48:51], s61 offen offset:1024 nt lds
    s_addk_i32 s61, 31744
    s_waitcnt vmcnt(23)
    buffer_load_dwordx4 v19, s[48:51], s61 offen offset:2048 nt lds
    s_addk_i32 s61, 31744
    s_waitcnt vmcnt(23)
    buffer_load_dwordx4 v19, s[48:51], s61 offen offset:3072 nt lds
    s_mov_b32 m0, 77824
    s_xor_b32 s61, s60, 0x63000
    s_waitcnt vmcnt(23)
    buffer_load_dwordx4 v18, s[48:51], s61 offen offset:0 nt lds
    s_addk_i32 s61, 31744
    s_waitcnt vmcnt(23)
    buffer_load_dwordx4 v18, s[48:51], s61 offen offset:1024 nt lds
    s_addk_i32 s61, 31744
    s_waitcnt vmcnt(23)
    buffer_load_dwordx4 v19, s[48:51], s61 offen offset:2048 nt lds
    s_addk_i32 s61, 31744
    s_waitcnt vmcnt(23)
    buffer_load_dwordx4 v19, s[48:51], s61 offen offset:3072 nt lds
    s_mov_b32 m0, 81920
    s_xor_b32 s61, s60, 0x84000
    s_waitcnt vmcnt(23)
    buffer_load_dwordx4 v18, s[48:51], s61 offen offset:0 nt lds
    s_addk_i32 s61, 31744
    s_waitcnt vmcnt(23)
    buffer_load_dwordx4 v18, s[48:51], s61 offen offset:1024 nt lds
    s_addk_i32 s61, 31744
    s_waitcnt vmcnt(23)
    buffer_load_dwordx4 v19, s[48:51], s61 offen offset:2048 nt lds
    s_addk_i32 s61, 31744
    s_waitcnt vmcnt(23)
    buffer_load_dwordx4 v19, s[48:51], s61 offen offset:3072 nt lds
    s_mov_b32 m0, 86016
    s_xor_b32 s61, s60, 0xa5000
    s_waitcnt vmcnt(23)
    buffer_load_dwordx4 v18, s[48:51], s61 offen offset:0 nt lds
    s_addk_i32 s61, 31744
    s_waitcnt vmcnt(23)
    buffer_load_dwordx4 v18, s[48:51], s61 offen offset:1024 nt lds
    s_addk_i32 s61, 31744
    s_waitcnt vmcnt(23)
    buffer_load_dwordx4 v19, s[48:51], s61 offen offset:2048 nt lds
    s_addk_i32 s61, 31744
    s_waitcnt vmcnt(23)
    s_barrier
    buffer_load_dwordx4 v19, s[48:51], s61 offen offset:3072 nt lds
    s_mov_b32 m0, 90112
    s_xor_b32 s61, s60, 0xc6000
    s_waitcnt vmcnt(23)
    buffer_load_dwordx4 v18, s[48:51], s61 offen offset:0 nt lds
    s_addk_i32 s61, 31744
    s_waitcnt vmcnt(23)
    buffer_load_dwordx4 v18, s[48:51], s61 offen offset:1024 nt lds
    s_addk_i32 s61, 31744
    s_waitcnt vmcnt(23)
    buffer_load_dwordx4 v19, s[48:51], s61 offen offset:2048 nt lds
    s_addk_i32 s61, 31744
    s_waitcnt vmcnt(23)
    buffer_load_dwordx4 v19, s[48:51], s61 offen offset:3072 nt lds
    s_mov_b32 m0, 94208
    s_xor_b32 s61, s60, 0xe7000
    s_waitcnt vmcnt(23)
    buffer_load_dwordx4 v18, s[48:51], s61 offen offset:0 nt lds
    s_addk_i32 s61, 31744
    s_waitcnt vmcnt(23)
    buffer_load_dwordx4 v18, s[48:51], s61 offen offset:1024 nt lds
    s_addk_i32 s61, 31744
    s_waitcnt vmcnt(23)
    buffer_load_dwordx4 v19, s[48:51], s61 offen offset:2048 nt lds
    s_addk_i32 s61, 31744
    s_waitcnt vmcnt(23)
    buffer_load_dwordx4 v19, s[48:51], s61 offen offset:3072 nt lds
    s_mov_b64 s[52:53], s[20:21]
    s_mov_b32 s54, 0x1c0000
    s_mov_b32 s55, 0x20000
    s_lshl_b32 s60, s28, 3
    s_lshr_b32 s62, s29, 2
    s_add_u32 s60, s60, s62
    s_sub_u32 s60, s60, 8
    s_lshl_b32 s60, s60, 15
    s_and_b32 s62, s29, 3
    s_lshl_b32 s62, s62, 8
    s_add_u32 s60, s60, s62
    s_mov_b32 m0, 98304
    s_nop 0
    buffer_load_dwordx4 v20, s[52:55], s60 offen offset:0 nt lds
    s_add_u32 s61, s60, 3072
    buffer_load_dwordx4 v20, s[52:55], s61 offen offset:1024 nt lds
    s_add_u32 s61, s60, 6144
    s_barrier
    buffer_load_dwordx4 v21, s[52:55], s61 offen offset:2048 nt lds
    s_add_u32 s61, s60, 9216
    buffer_load_dwordx4 v21, s[52:55], s61 offen offset:3072 nt lds
    s_mov_b32 m0, 102400
    s_add_u32 s61, s60, 16384
    buffer_load_dwordx4 v20, s[52:55], s61 offen offset:0 nt lds
    s_add_u32 s61, s60, 19456
    s_barrier
    buffer_load_dwordx4 v20, s[52:55], s61 offen offset:1024 nt lds
    s_add_u32 s61, s60, 22528
    buffer_load_dwordx4 v21, s[52:55], s61 offen offset:2048 nt lds
    s_add_u32 s61, s60, 25600
    s_barrier
    s_waitcnt vmcnt(15)
    buffer_load_dwordx4 v21, s[52:55], s61 offen offset:3072 nt lds
    s_mov_b64 s[56:57], s[12:13]
    s_mov_b32 s58, 0x400000
    s_mov_b32 s59, 0x20000
    s_lshl_b32 s60, s28, 3
    s_lshr_b32 s62, s29, 2
    s_add_u32 s60, s60, s62
    s_lshl_b32 s60, s60, 16
    s_and_b32 s62, s29, 3
    s_lshl_b32 s62, s62, 8
    s_add_u32 s60, s60, s62
    s_mov_b32 m0, 106496
    s_waitcnt vmcnt(15)
    buffer_load_dwordx4 v20, s[56:59], s60 offen offset:0 nt lds
    s_add_u32 s61, s60, 3072
    s_waitcnt vmcnt(15)
    buffer_load_dwordx4 v20, s[56:59], s61 offen offset:1024 nt lds
    s_add_u32 s61, s60, 6144
    s_waitcnt vmcnt(15)
    buffer_load_dwordx4 v21, s[56:59], s61 offen offset:2048 nt lds
    s_add_u32 s61, s60, 9216
    s_waitcnt vmcnt(15)
    buffer_load_dwordx4 v21, s[56:59], s61 offen offset:3072 nt lds
    s_mov_b32 m0, 110592
    s_add_u32 s61, s60, 16384
    s_waitcnt vmcnt(15)
    buffer_load_dwordx4 v20, s[56:59], s61 offen offset:0 nt lds
    s_add_u32 s61, s60, 19456
    s_waitcnt vmcnt(15)
    buffer_load_dwordx4 v20, s[56:59], s61 offen offset:1024 nt lds
    s_add_u32 s61, s60, 22528
    s_waitcnt vmcnt(15)
    buffer_load_dwordx4 v21, s[56:59], s61 offen offset:2048 nt lds
    s_add_u32 s61, s60, 25600
    s_waitcnt vmcnt(15)
    s_barrier
    buffer_load_dwordx4 v21, s[56:59], s61 offen offset:3072 nt lds
    s_mov_b32 m0, 114688
    s_add_u32 s61, s60, 32768
    s_waitcnt vmcnt(15)
    buffer_load_dwordx4 v20, s[56:59], s61 offen offset:0 nt lds
    s_add_u32 s61, s60, 35840
    s_waitcnt vmcnt(15)
    buffer_load_dwordx4 v20, s[56:59], s61 offen offset:1024 nt lds
    s_add_u32 s61, s60, 38912
    s_waitcnt vmcnt(15)
    buffer_load_dwordx4 v21, s[56:59], s61 offen offset:2048 nt lds
    s_add_u32 s61, s60, 41984
    s_waitcnt vmcnt(15)
    buffer_load_dwordx4 v21, s[56:59], s61 offen offset:3072 nt lds
    s_mov_b32 m0, 118784
    s_add_u32 s61, s60, 49152
    s_waitcnt vmcnt(15)
    buffer_load_dwordx4 v20, s[56:59], s61 offen offset:0 nt lds
    s_add_u32 s61, s60, 52224
    s_waitcnt vmcnt(15)
    buffer_load_dwordx4 v20, s[56:59], s61 offen offset:1024 nt lds
    s_add_u32 s61, s60, 55296
    s_waitcnt vmcnt(15)
    buffer_load_dwordx4 v21, s[56:59], s61 offen offset:2048 nt lds
    s_add_u32 s61, s60, 58368
    s_waitcnt vmcnt(15)
    buffer_load_dwordx4 v21, s[56:59], s61 offen offset:3072 nt lds
    s_waitcnt vmcnt(8)
    s_barrier
    s_waitcnt vmcnt(0)
    s_barrier
    s_endpgm
L_light:
    s_mov_b64 s[44:45], s[6:7]
    s_mov_b32 s46, 0x8000000
    s_mov_b32 s47, 0x20000
    s_lshl_b32 s60, s28, 24
    s_lshl_b32 s62, s29, 10
    s_add_u32 s60, s60, s62
    s_add_u32 s60, s60, 15728640
    v_lshrrev_b32 v5, 4, v0
    v_and_b32 v6, 0xf0, v3
    v_lshlrev_b32 v7, 4, v5
    v_xor_b32 v14, v6, v7
    v_lshl_add_u32 v14, v5, 8, v14
    v_xor_b32 v15, 64, v14
    v_xor_b32 v16, 128, v14
    v_xor_b32 v17, 192, v14
    s_mov_b32 m0, 32768
    s_nop 0
    buffer_load_dwordx4 v14, s[44:47], s60 offen offset:0 nt lds
    s_add_u32 s61, s60, 31744
    buffer_load_dwordx4 v15, s[44:47], s61 offen offset:1024 nt lds
    s_addk_i32 s61, 31744
    buffer_load_dwordx4 v16, s[44:47], s61 offen offset:2048 nt lds
    s_addk_i32 s61, 31744
    buffer_load_dwordx4 v17, s[44:47], s61 offen offset:3072 nt lds
    s_mov_b32 m0, 36864
    s_xor_b32 s61, s60, 0x21000
    s_waitcnt vmcnt(19)
    buffer_load_dwordx4 v14, s[44:47], s61 offen offset:0 nt lds
    s_addk_i32 s61, 31744
    s_waitcnt vmcnt(19)
    buffer_load_dwordx4 v15, s[44:47], s61 offen offset:1024 nt lds
    s_addk_i32 s61, 31744
    s_waitcnt vmcnt(19)
    buffer_load_dwordx4 v16, s[44:47], s61 offen offset:2048 nt lds
    s_addk_i32 s61, 31744
    s_waitcnt vmcnt(19)
    buffer_load_dwordx4 v17, s[44:47], s61 offen offset:3072 nt lds
    s_mov_b32 m0, 40960
    s_xor_b32 s61, s60, 0x42000
    s_waitcnt vmcnt(19)
    buffer_load_dwordx4 v14, s[44:47], s61 offen offset:0 nt lds
    s_addk_i32 s61, 31744
    s_waitcnt vmcnt(19)
    buffer_load_dwordx4 v15, s[44:47], s61 offen offset:1024 nt lds
    s_addk_i32 s61, 31744
    s_waitcnt vmcnt(19)
    buffer_load_dwordx4 v16, s[44:47], s61 offen offset:2048 nt lds
    s_addk_i32 s61, 31744
    s_waitcnt vmcnt(19)
    buffer_load_dwordx4 v17, s[44:47], s61 offen offset:3072 nt lds
    s_mov_b32 m0, 45056
    s_xor_b32 s61, s60, 0x63000
    s_waitcnt vmcnt(19)
    buffer_load_dwordx4 v14, s[44:47], s61 offen offset:0 nt lds
    s_addk_i32 s61, 31744
    s_waitcnt vmcnt(19)
    buffer_load_dwordx4 v15, s[44:47], s61 offen offset:1024 nt lds
    s_addk_i32 s61, 31744
    s_waitcnt vmcnt(19)
    buffer_load_dwordx4 v16, s[44:47], s61 offen offset:2048 nt lds
    s_addk_i32 s61, 31744
    s_waitcnt vmcnt(19)
    buffer_load_dwordx4 v17, s[44:47], s61 offen offset:3072 nt lds
    s_mov_b32 m0, 49152
    s_xor_b32 s61, s60, 0x84000
    s_waitcnt vmcnt(19)
    buffer_load_dwordx4 v14, s[44:47], s61 offen offset:0 nt lds
    s_addk_i32 s61, 31744
    s_waitcnt vmcnt(19)
    buffer_load_dwordx4 v15, s[44:47], s61 offen offset:1024 nt lds
    s_addk_i32 s61, 31744
    s_waitcnt vmcnt(19)
    buffer_load_dwordx4 v16, s[44:47], s61 offen offset:2048 nt lds
    s_addk_i32 s61, 31744
    s_waitcnt vmcnt(19)
    s_barrier
    buffer_load_dwordx4 v17, s[44:47], s61 offen offset:3072 nt lds
    s_mov_b32 m0, 53248
    s_xor_b32 s61, s60, 0xa5000
    s_waitcnt vmcnt(19)
    buffer_load_dwordx4 v14, s[44:47], s61 offen offset:0 nt lds
    s_addk_i32 s61, 31744
    s_waitcnt vmcnt(19)
    buffer_load_dwordx4 v15, s[44:47], s61 offen offset:1024 nt lds
    s_addk_i32 s61, 31744
    s_waitcnt vmcnt(19)
    buffer_load_dwordx4 v16, s[44:47], s61 offen offset:2048 nt lds
    s_addk_i32 s61, 31744
    s_waitcnt vmcnt(19)
    buffer_load_dwordx4 v17, s[44:47], s61 offen offset:3072 nt lds
    s_mov_b32 m0, 57344
    s_xor_b32 s61, s60, 0xc6000
    s_waitcnt vmcnt(19)
    buffer_load_dwordx4 v14, s[44:47], s61 offen offset:0 nt lds
    s_addk_i32 s61, 31744
    s_waitcnt vmcnt(19)
    buffer_load_dwordx4 v15, s[44:47], s61 offen offset:1024 nt lds
    s_addk_i32 s61, 31744
    s_waitcnt vmcnt(19)
    buffer_load_dwordx4 v16, s[44:47], s61 offen offset:2048 nt lds
    s_addk_i32 s61, 31744
    s_waitcnt vmcnt(19)
    buffer_load_dwordx4 v17, s[44:47], s61 offen offset:3072 nt lds
    s_mov_b32 m0, 61440
    s_xor_b32 s61, s60, 0xe7000
    s_waitcnt vmcnt(19)
    buffer_load_dwordx4 v14, s[44:47], s61 offen offset:0 nt lds
    s_addk_i32 s61, 31744
    s_waitcnt vmcnt(19)
    buffer_load_dwordx4 v15, s[44:47], s61 offen offset:1024 nt lds
    s_addk_i32 s61, 31744
    s_waitcnt vmcnt(19)
    buffer_load_dwordx4 v16, s[44:47], s61 offen offset:2048 nt lds
    s_addk_i32 s61, 31744
    s_waitcnt vmcnt(19)
    buffer_load_dwordx4 v17, s[44:47], s61 offen offset:3072 nt lds
    s_mov_b64 s[48:49], s[8:9]
    s_mov_b32 s50, 0x8000000
    s_mov_b32 s51, 0x20000
    s_lshl_b32 s60, s28, 24
    s_lshl_b32 s62, s29, 10
    s_add_u32 s60, s60, s62
    s_add_u32 s60, s60, 15728640
    v_lshrrev_b32 v5, 4, v0
    v_and_b32 v6, 0xf0, v3
    v_lshlrev_b32 v7, 5, v5
    v_xor_b32 v6, v6, v7
    v_lshl_add_u32 v18, v5, 8, v6
    v_xor_b32 v19, 128, v18
    v_lshl_add_u32 v20, v5, 10, v6
    v_xor_b32 v21, 128, v20
    s_mov_b32 m0, 65536
    s_waitcnt vmcnt(19)
    buffer_load_dwordx4 v18, s[48:51], s60 offen offset:0 nt lds
    s_add_u32 s61, s60, 31744
    s_waitcnt vmcnt(19)
    buffer_load_dwordx4 v18, s[48:51], s61 offen offset:1024 nt lds
    s_addk_i32 s61, 31744
    s_waitcnt vmcnt(19)
    buffer_load_dwordx4 v19, s[48:51], s61 offen offset:2048 nt lds
    s_addk_i32 s61, 31744
    s_waitcnt vmcnt(19)
    buffer_load_dwordx4 v19, s[48:51], s61 offen offset:3072 nt lds
    s_mov_b32 m0, 69632
    s_xor_b32 s61, s60, 0x21000
    s_waitcnt vmcnt(19)
    buffer_load_dwordx4 v18, s[48:51], s61 offen offset:0 nt lds
    s_addk_i32 s61, 31744
    s_waitcnt vmcnt(19)
    buffer_load_dwordx4 v18, s[48:51], s61 offen offset:1024 nt lds
    s_addk_i32 s61, 31744
    s_waitcnt vmcnt(19)
    buffer_load_dwordx4 v19, s[48:51], s61 offen offset:2048 nt lds
    s_addk_i32 s61, 31744
    s_waitcnt vmcnt(19)
    buffer_load_dwordx4 v19, s[48:51], s61 offen offset:3072 nt lds
    s_mov_b32 m0, 73728
    s_xor_b32 s61, s60, 0x42000
    s_waitcnt vmcnt(19)
    buffer_load_dwordx4 v18, s[48:51], s61 offen offset:0 nt lds
    s_addk_i32 s61, 31744
    s_waitcnt vmcnt(19)
    buffer_load_dwordx4 v18, s[48:51], s61 offen offset:1024 nt lds
    s_addk_i32 s61, 31744
    s_waitcnt vmcnt(19)
    buffer_load_dwordx4 v19, s[48:51], s61 offen offset:2048 nt lds
    s_addk_i32 s61, 31744
    s_waitcnt vmcnt(19)
    buffer_load_dwordx4 v19, s[48:51], s61 offen offset:3072 nt lds
    s_mov_b32 m0, 77824
    s_xor_b32 s61, s60, 0x63000
    s_waitcnt vmcnt(19)
    buffer_load_dwordx4 v18, s[48:51], s61 offen offset:0 nt lds
    s_addk_i32 s61, 31744
    s_waitcnt vmcnt(19)
    buffer_load_dwordx4 v18, s[48:51], s61 offen offset:1024 nt lds
    s_addk_i32 s61, 31744
    s_waitcnt vmcnt(19)
    buffer_load_dwordx4 v19, s[48:51], s61 offen offset:2048 nt lds
    s_addk_i32 s61, 31744
    s_waitcnt vmcnt(19)
    s_barrier
    buffer_load_dwordx4 v19, s[48:51], s61 offen offset:3072 nt lds
    s_mov_b32 m0, 81920
    s_xor_b32 s61, s60, 0x84000
    s_waitcnt vmcnt(19)
    buffer_load_dwordx4 v18, s[48:51], s61 offen offset:0 nt lds
    s_addk_i32 s61, 31744
    s_waitcnt vmcnt(19)
    buffer_load_dwordx4 v18, s[48:51], s61 offen offset:1024 nt lds
    s_addk_i32 s61, 31744
    s_waitcnt vmcnt(19)
    buffer_load_dwordx4 v19, s[48:51], s61 offen offset:2048 nt lds
    s_addk_i32 s61, 31744
    s_waitcnt vmcnt(19)
    s_barrier
    buffer_load_dwordx4 v19, s[48:51], s61 offen offset:3072 nt lds
    s_mov_b32 m0, 86016
    s_xor_b32 s61, s60, 0xa5000
    s_waitcnt vmcnt(19)
    buffer_load_dwordx4 v18, s[48:51], s61 offen offset:0 nt lds
    s_addk_i32 s61, 31744
    s_waitcnt vmcnt(19)
    buffer_load_dwordx4 v18, s[48:51], s61 offen offset:1024 nt lds
    s_addk_i32 s61, 31744
    s_waitcnt vmcnt(19)
    buffer_load_dwordx4 v19, s[48:51], s61 offen offset:2048 nt lds
    s_addk_i32 s61, 31744
    s_waitcnt vmcnt(19)
    buffer_load_dwordx4 v19, s[48:51], s61 offen offset:3072 nt lds
    s_mov_b32 m0, 90112
    s_xor_b32 s61, s60, 0xc6000
    s_waitcnt vmcnt(19)
    buffer_load_dwordx4 v18, s[48:51], s61 offen offset:0 nt lds
    s_addk_i32 s61, 31744
    s_waitcnt vmcnt(19)
    buffer_load_dwordx4 v18, s[48:51], s61 offen offset:1024 nt lds
    s_addk_i32 s61, 31744
    s_waitcnt vmcnt(19)
    buffer_load_dwordx4 v19, s[48:51], s61 offen offset:2048 nt lds
    s_addk_i32 s61, 31744
    s_waitcnt vmcnt(19)
    buffer_load_dwordx4 v19, s[48:51], s61 offen offset:3072 nt lds
    s_mov_b32 m0, 94208
    s_xor_b32 s61, s60, 0xe7000
    s_waitcnt vmcnt(19)
    buffer_load_dwordx4 v18, s[48:51], s61 offen offset:0 nt lds
    s_addk_i32 s61, 31744
    s_waitcnt vmcnt(19)
    buffer_load_dwordx4 v18, s[48:51], s61 offen offset:1024 nt lds
    s_addk_i32 s61, 31744
    s_waitcnt vmcnt(19)
    buffer_load_dwordx4 v19, s[48:51], s61 offen offset:2048 nt lds
    s_addk_i32 s61, 31744
    s_waitcnt vmcnt(19)
    buffer_load_dwordx4 v19, s[48:51], s61 offen offset:3072 nt lds
    s_mov_b64 s[56:57], s[12:13]
    s_mov_b32 s58, 0x400000
    s_mov_b32 s59, 0x20000
    s_lshl_b32 s60, s28, 3
    s_lshr_b32 s62, s29, 2
    s_add_u32 s60, s60, s62
    s_lshl_b32 s60, s60, 16
    s_and_b32 s62, s29, 3
    s_lshl_b32 s62, s62, 8
    s_add_u32 s60, s60, s62
    s_mov_b32 m0, 106496
    s_waitcnt vmcnt(19)
    buffer_load_dwordx4 v20, s[56:59], s60 offen offset:0 nt lds
    s_add_u32 s61, s60, 3072
    s_waitcnt vmcnt(19)
    buffer_load_dwordx4 v20, s[56:59], s61 offen offset:1024 nt lds
    s_add_u32 s61, s60, 6144
    s_waitcnt vmcnt(19)
    buffer_load_dwordx4 v21, s[56:59], s61 offen offset:2048 nt lds
    s_add_u32 s61, s60, 9216
    s_waitcnt vmcnt(19)
    buffer_load_dwordx4 v21, s[56:59], s61 offen offset:3072 nt lds
    s_mov_b32 m0, 110592
    s_add_u32 s61, s60, 16384
    buffer_load_dwordx4 v20, s[56:59], s61 offen offset:0 nt lds
    s_add_u32 s61, s60, 19456
    buffer_load_dwordx4 v20, s[56:59], s61 offen offset:1024 nt lds
    s_add_u32 s61, s60, 22528
    s_barrier
    buffer_load_dwordx4 v21, s[56:59], s61 offen offset:2048 nt lds
    s_add_u32 s61, s60, 25600
    buffer_load_dwordx4 v21, s[56:59], s61 offen offset:3072 nt lds
    s_mov_b32 m0, 114688
    s_add_u32 s61, s60, 32768
    buffer_load_dwordx4 v20, s[56:59], s61 offen offset:0 nt lds
    s_add_u32 s61, s60, 35840
    s_barrier
    buffer_load_dwordx4 v20, s[56:59], s61 offen offset:1024 nt lds
    s_add_u32 s61, s60, 38912
    buffer_load_dwordx4 v21, s[56:59], s61 offen offset:2048 nt lds
    s_add_u32 s61, s60, 41984
    s_barrier
    s_waitcnt vmcnt(19)
    buffer_load_dwordx4 v21, s[56:59], s61 offen offset:3072 nt lds
    s_mov_b32 m0, 118784
    s_add_u32 s61, s60, 49152
    s_waitcnt vmcnt(19)
    buffer_load_dwordx4 v20, s[56:59], s61 offen offset:0 nt lds
    s_add_u32 s61, s60, 52224
    s_waitcnt vmcnt(19)
    buffer_load_dwordx4 v20, s[56:59], s61 offen offset:1024 nt lds
    s_add_u32 s61, s60, 55296
    s_waitcnt vmcnt(19)
    buffer_load_dwordx4 v21, s[56:59], s61 offen offset:2048 nt lds
    s_add_u32 s61, s60, 58368
    s_waitcnt vmcnt(19)
    buffer_load_dwordx4 v21, s[56:59], s61 offen offset:3072 nt lds
    s_waitcnt vmcnt(16)
    s_barrier
    s_waitcnt vmcnt(8)
    s_barrier
    s_waitcnt vmcnt(0)
    s_barrier
    s_endpgm
L_compute:
    v_subrev_u32 v0, 64, v0
    s_lshr_b32 s3, s3, 6
    s_sub_u32 s3, s3, 1
    v_and_b32 v1, 63, v0
    s_waitcnt lgkmcnt(0)
    s_load_dword s48, s[26:27], 0
    s_getreg_b32 s43, hwreg(HW_REG_XCC_ID, 0, 4)
    v_lshrrev_b32 v2, 4, v1
    v_and_b32 v3, 15, v1
    s_and_b32 s45, s3, 3
    s_lshr_b32 s37, s29, 2
    s_lshl_b32 s56, s28, 16
    s_lshl_b32 s57, s29, 11
    s_add_u32 s56, s56, s57
    s_add_u32 s60, s56, 0x80000
    s_lshr_b32 s57, s56, 3
    s_add_u32 s61, s57, 0x10000
    s_lshr_b32 s57, s56, 2
    s_add_u32 s62, s57, 0x20000
    s_lshl_b32 s56, s28, 11
    s_lshl_b32 s57, s29, 4
    s_add_u32 s56, s56, s57
    s_add_u32 s63, s56, 0x40000
    s_mov_b32 s51, 0xffffff00
    v_lshrrev_b32 v6, 2, v3
    v_and_b32 v7, 3, v3
    v_lshlrev_b32 v7, 3, v7
    v_lshl_add_u32 v8, v2, 3, v6
    v_and_b32 v9, 1, v2
    v_lshrrev_b32 v10, 1, v6
    v_lshl_add_u32 v10, v9, 1, v10
    v_xor_b32 v10, s45, v10
    v_lshl_add_u32 v10, v10, 5, v7
    v_lshl_add_u32 v16, v8, 7, v10
    s_lshr_b32 s59, s3, 2
    s_lshl_b32 s56, s59, 13
    s_add_u32 s56, s56, 16384
    v_add_u32 v17, s56, v16
    s_lshr_b32 s56, s29, 3
    s_lshl_b32 s56, s56, 8
    s_add_u32 s56, s56, 122880
    v_lshl_add_u32 v14, v2, 4, s56
    s_lshl_b32 s56, s37, 7
    s_add_u32 s56, s56, 122880
    v_lshl_add_u32 v15, v2, 4, s56
    s_lshl_b32 s57, s45, 6
    s_add_u32 s56, s57, s61
    v_lshl_add_u32 v18, v3, 2, s56
    s_lshr_b32 s56, s45, 1
    s_add_u32 s56, s56, s59
    s_lshl_b32 s56, s56, 7
    s_add_u32 s56, s56, s57
    s_add_u32 s56, s56, s62
    v_lshl_add_u32 v19, v3, 2, s56
    s_waitcnt lgkmcnt(0)
    s_add_u32 s48, s48, 0x61c88647
    s_xor_b32 s54, s48, s43
    v_bfe_u32 v5, s48, v7, 8
    v_bfe_u32 v4, s54, v7, 8
    s_cmp_lg_u32 s3, 0
    s_cbranch_scc1 L_noln
    s_waitcnt vmcnt(0)
    v_lshlrev_b32 v52, 16, v24
    v_and_b32 v53, 0xffff0000, v24
    v_lshlrev_b32 v54, 16, v25
    v_and_b32 v55, 0xffff0000, v25
    v_lshlrev_b32 v56, 16, v26
    v_and_b32 v57, 0xffff0000, v26
    v_lshlrev_b32 v58, 16, v27
    v_and_b32 v59, 0xffff0000, v27
    v_pk_add_f32 v[60:61], v[52:53], v[54:55]
    v_pk_add_f32 v[62:63], v[56:57], v[58:59]
    v_pk_add_f32 v[60:61], v[60:61], v[62:63]
    v_add_f32 v68, v60, v61
    s_nop 1
    v_add_f32_dpp v68, v68, v68 quad_perm:[1,0,3,2] row_mask:0xf bank_mask:0xf
    s_nop 1
    v_add_f32_dpp v68, v68, v68 quad_perm:[2,3,0,1] row_mask:0xf bank_mask:0xf
    s_nop 1
    v_add_f32_dpp v68, v68, v68 row_half_mirror row_mask:0xf bank_mask:0xf
    s_nop 1
    v_add_f32_dpp v68, v68, v68 row_mirror row_mask:0xf bank_mask:0xf
    s_nop 1
    v_add_f32_dpp v68, v68, v68 row_bcast:15 row_mask:0xa bank_mask:0xf
    s_nop 1
    v_add_f32_dpp v68, v68, v68 row_bcast:31 row_mask:0xc bank_mask:0xf
    s_nop 0
    v_readlane_b32 s56, v68, 63
    v_mov_b32 v71, 0x3b000000
    s_nop 0
    v_mul_f32 v69, s56, v71
    v_sub_f32 v60, v52, v69
    v_sub_f32 v61, v53, v69
    v_sub_f32 v62, v54, v69
    v_sub_f32 v63, v55, v69
    v_sub_f32 v64, v56, v69
    v_sub_f32 v65, v57, v69
    v_sub_f32 v66, v58, v69
    v_sub_f32 v67, v59, v69
    v_mul_f32 v68, v60, v60
    v_mul_f32 v70, v61, v61
    v_fmac_f32 v68, v62, v62
    v_fmac_f32 v70, v63, v63
    v_fmac_f32 v68, v64, v64
    v_fmac_f32 v70, v65, v65
    v_fmac_f32 v68, v66, v66
    v_fmac_f32 v70, v67, v67
    v_add_f32 v68, v68, v70
    v_cvt_pk_bf16_f32 v69, 0, v69
    s_nop 0
    v_add_f32_dpp v68, v68, v68 quad_perm:[1,0,3,2] row_mask:0xf bank_mask:0xf
    s_nop 1
    v_add_f32_dpp v68, v68, v68 quad_perm:[2,3,0,1] row_mask:0xf bank_mask:0xf
    s_nop 1
    v_add_f32_dpp v68, v68, v68 row_half_mirror row_mask:0xf bank_mask:0xf
    s_nop 1
    v_add_f32_dpp v68, v68, v68 row_mirror row_mask:0xf bank_mask:0xf
    s_nop 1
    v_add_f32_dpp v68, v68, v68 row_bcast:15 row_mask:0xa bank_mask:0xf
    s_nop 1
    v_add_f32_dpp v68, v68, v68 row_bcast:31 row_mask:0xc bank_mask:0xf
    s_nop 0
    v_readlane_b32 s56, v68, 63
    v_sub_f32 v52, v52, v69
    v_sub_f32 v53, v53, v69
    v_sub_f32 v54, v54, v69
    v_sub_f32 v55, v55, v69
    v_sub_f32 v56, v56, v69
    v_sub_f32 v57, v57, v69
    v_sub_f32 v58, v58, v69
    v_sub_f32 v59, v59, v69
    v_mul_f32 v70, s56, v71
    v_cvt_pk_bf16_f32 v70, 0, v70
    v_add_f32 v70, 0x3727c5ac, v70
    v_cvt_pk_bf16_f32 v70, 0, v70
    v_sqrt_f32 v70, v70
    v_cvt_pk_bf16_f32 v52, 0, v52
    v_cvt_pk_bf16_f32 v53, 0, v53
    v_cvt_pk_bf16_f32 v54, 0, v54
    v_cvt_pk_bf16_f32 v55, 0, v55
    v_cvt_pk_bf16_f32 v56, 0, v56
    v_cvt_pk_bf16_f32 v57, 0, v57
    v_cvt_pk_bf16_f32 v58, 0, v58
    v_cvt_pk_bf16_f32 v59, 0, v59
    v_cvt_pk_bf16_f32 v70, 0, v70
    v_rcp_f32 v70, v70
    v_mov_b32 v68, 122880
    v_lshl_add_u32 v68, v1, 4, v68
    v_mul_f32 v52, v52, v70
    v_mul_f32 v53, v53, v70
    v_mul_f32 v54, v54, v70
    v_mul_f32 v55, v55, v70
    v_mul_f32 v56, v56, v70
    v_mul_f32 v57, v57, v70
    v_mul_f32 v58, v58, v70
    v_mul_f32 v59, v59, v70
    v_cvt_pk_bf16_f32 v24, v52, v53
    v_cvt_pk_bf16_f32 v25, v54, v55
    v_cvt_pk_bf16_f32 v26, v56, v57
    v_cvt_pk_bf16_f32 v27, v58, v59
    ds_write_b128 v68, v[24:27]
    s_waitcnt lgkmcnt(0)
L_noln:
    s_cmp_ge_u32 s3, 4
    s_barrier
    s_cbranch_scc1 L_noq
    ds_read_b128 v[52:55], v14 offset:0
    ds_read_b64_tr_b16 v[68:69], v16 offset:0
    ds_read_b64_tr_b16 v[70:71], v16 offset:512
    ds_read_b128 v[56:59], v14 offset:64
    ds_read_b64_tr_b16 v[72:73], v16 offset:4096
    ds_read_b64_tr_b16 v[74:75], v16 offset:4608
    ds_read_b128 v[60:63], v14 offset:128
    ds_read_b64_tr_b16 v[76:77], v16 offset:8192
    ds_read_b64_tr_b16 v[78:79], v16 offset:8704
    ds_read_b128 v[64:67], v14 offset:192
    ds_read_b64_tr_b16 v[80:81], v16 offset:12288
    ds_read_b64_tr_b16 v[82:83], v16 offset:12800
    s_waitcnt lgkmcnt(9)
    v_mfma_f32_16x16x32_bf16 v[36:39], v[52:55], v[68:71], 0
    s_waitcnt lgkmcnt(6)
    v_mfma_f32_16x16x32_bf16 v[36:39], v[56:59], v[72:75], v[36:39]
    s_waitcnt lgkmcnt(3)
    v_mfma_f32_16x16x32_bf16 v[36:39], v[60:63], v[76:79], v[36:39]
    s_waitcnt lgkmcnt(0)
    v_mfma_f32_16x16x32_bf16 v[36:39], v[64:67], v[80:83], v[36:39]
    s_mov_b64 exec, 0xffff
    s_nop 6
    v_and_or_b32 v36, v36, s51, v4
    global_store_dword v18, v36, s[26:27]
    s_mov_b64 exec, -1
L_noq:
    ds_read_b128 v[52:55], v15 offset:0
    ds_read_b128 v[56:59], v15 offset:64
    s_mov_b32 s49, 0x0c0c0400
    s_mov_b32 s50, 0x04000c0c
    s_mov_b32 s55, 0x3fb8aa3b
    s_mov_b32 s44, 0x3db504f3
    v_lshlrev_b32 v11, 4, v3
    v_lshl_add_u32 v11, v2, 11, v11
    s_lshl_b32 s56, s28, 13
    s_lshl_b32 s57, s3, 8
    s_add_u32 s56, s56, s57
    s_add_u32 s56, s56, 0x10000
    v_add_u32 v20, s56, v11
    s_lshl_b32 s58, s37, 8
    s_lshl_b32 s56, s28, 14
    s_add_u32 s56, s56, s58
    s_add_u32 s56, s56, 0x20000
    v_add_u32 v119, s56, v11
    v_add_u32 v120, 8192, v119
    s_lshl_b32 s56, s28, 16
    s_lshl_b32 s57, s45, 14
    s_add_u32 s56, s56, s57
    s_add_u32 s56, s56, s58
    s_add_u32 s56, s56, 0x80000
    v_add_u32 v117, s56, v11
    v_add_u32 v118, 8192, v117
    v_lshl_add_u32 v10, v9, 2, v6
    v_lshl_add_u32 v10, v10, 5, v7
    v_lshl_add_u32 v10, v8, 8, v10
    s_lshl_b32 s56, s3, 5
    s_add_u32 s56, s56, 65536
    v_xor_b32 v115, s56, v10
    s_cmp_ge_u32 s3, 4
    s_cselect_b32 s57, 0, 8192
    s_lshl_b32 s56, s45, 6
    s_add_u32 s57, s57, 98304
    s_add_u32 s56, s56, s57
    v_xor_b32 v121, s56, v10
    v_xor_b32 v122, 32, v121
    v_mul_u32_u24 v111, 288, v6
    v_lshl_add_u32 v111, v2, 4, v111
    v_add_u32 v111, 123904, v111
    s_lshr_b32 s56, s3, 1
    s_mul_i32 s56, s56, 288
    s_and_b32 s57, s3, 1
    s_lshl_b32 s57, s57, 7
    s_add_u32 s56, s56, s57
    s_add_u32 s56, s56, 123904
    v_lshl_add_u32 v110, v3, 2, v2
    v_lshl_add_u32 v110, v110, 1, s56
    s_cmp_eq_u32 s28, 0
    s_cbranch_scc1 L_nogu
    s_barrier
    ds_read_b64_tr_b16 v[68:69], v17 offset:0
    ds_read_b64_tr_b16 v[70:71], v17 offset:512
    ds_read_b64_tr_b16 v[72:73], v17 offset:4096
    ds_read_b64_tr_b16 v[74:75], v17 offset:4608
    s_waitcnt lgkmcnt(2)
    v_mfma_f32_16x16x32_bf16 v[36:39], v[52:55], v[68:71], 0
    s_waitcnt lgkmcnt(0)
    v_mfma_f32_16x16x32_bf16 v[36:39], v[56:59], v[72:75], v[36:39]
    s_mov_b64 exec, 0xffff
    s_nop 6
    v_and_or_b32 v36, v36, s51, v4
    global_store_dword v19, v36, s[26:27]
    s_mov_b64 exec, -1
L_nogu:
    s_lshl_b32 s56, s3, 12
    s_add_u32 s56, s56, 32768
    v_xor_b32 v106, v3, v2
    v_lshl_add_u32 v106, v106, 4, s56
    v_lshl_add_u32 v106, v3, 8, v106
    v_xor_b32 v107, 64, v106
    v_xor_b32 v108, 128, v106
    v_xor_b32 v109, 192, v106
    s_lshl_b32 s56, s3, 2
    v_lshlrev_b32 v113, 5, v2
    v_add_u32 v113, 125056, v113
    v_add_u32 v112, s56, v113
    s_lshl_b32 s56, s3, 5
    s_add_u32 s56, s56, 125184
    v_mul_u32_u24 v114, 288, v2
    v_lshl_add_u32 v114, v3, 1, v114
    v_add_u32 v114, s56, v114
    s_lshl_b32 s56, s3, 6
    s_add_u32 s56, s56, s60
    v_lshl_add_u32 v116, v3, 2, s56
    v_lshl_add_u32 v116, v2, 9, v116
    s_barrier
    global_load_dwordx4 v[24:27], v20, s[26:27] offset:0 sc1
    v_mov_b32 v48, 0x3f803f80
    v_mov_b32 v49, 0x3f803f80
    v_mov_b32 v50, 0x3f803f80
    v_mov_b32 v51, 0x3f803f80
    v_lshl_add_u32 v19, v2, 9, s63
    v_and_b32 v6, 3, v1
    v_lshl_add_u32 v126, v6, 9, s63
    s_mov_b64 exec, 0xffff
    v_lshl_add_u32 v126, v1, 7, s60
    s_mov_b64 exec, -1
    s_and_b32 s56, s29, 3
    s_lshl_b32 s56, s56, 2
    s_add_u32 s56, s56, s45
    s_lshl_b32 s58, s56, 14
    s_lshl_b32 s56, s28, 3
    s_add_u32 s56, s56, s37
    s_lshl_b32 s56, s56, 7
    s_add_u32 s56, s56, s58
    s_cmp_ge_u32 s3, 4
    s_cselect_b32 s57, 0x40000, 0
    s_add_u32 s56, s56, s57
    s_add_u32 s56, s56, 0x200000
    v_and_b32 v8, 31, v1
    v_lshl_add_u32 v124, v8, 2, s56
    s_lshl_b32 s56, s28, 5
    s_add_u32 s56, s56, s37
    s_lshl_b32 s56, s56, 2
    s_add_u32 s56, s56, s58
    s_add_u32 s56, s56, 0x282000
    v_writelane_b32 v124, s56, 32
    s_lshr_b32 s56, s29, 3
    s_lshl_b32 s56, s56, 2
    s_and_b32 s53, s29, 3
    s_or_b32 s53, s53, s56
    s_and_b32 s56, s2, 39
    s_cselect_b32 s53, -1, s53
    s_cmp_eq_u32 s3, 3
    s_cselect_b32 s36, s28, 0
    v_and_b32 v9, 7, v1
    v_lshl_add_u32 v7, v9, 2, v2
    v_lshlrev_b32 v14, 1, v7
    v_add_u32 v14, 126336, v14
    v_lshlrev_b32 v15, 4, v2
    v_add_u32 v15, 126336, v15
    s_lshl_b32 s56, s3, 2
    s_add_u32 s56, s56, 131008
    v_mul_u32_u24 v16, 48, v7
    v_add_u32 v16, s56, v16
    v_mul_u32_u24 v17, 48, v1
    v_add_u32 v17, 131008, v17
    s_and_b32 s57, s53, 15
    s_lshl_b32 s56, s57, 6
    v_lshl_add_u32 v18, v8, 1, s56
    s_lshl_b32 s58, s57, 14
    s_lshl_b32 s57, s3, 7
    s_add_u32 s56, s58, s57
    s_add_u32 s56, s56, 0x282000
    s_add_u32 s34, s26, s56
    s_addc_u32 s35, s27, 0
    s_add_u32 s56, s58, 0x200000
    v_lshl_add_u32 v125, v0, 4, s56
    s_cmp_ge_u32 s53, 16
    s_cbranch_scc1 L_nocr
    s_load_dwordx8 s[8:15], s[34:35], 0 glc

L_nocr:
    s_cmp_ge_u32 s3, 4
    s_cbranch_scc1 L_sB
    v_mul_u32_u24 v123, 144, v3
    v_lshl_add_u32 v123, v2, 4, v123
    v_add_u32 v123, 126400, v123
    s_lshl_b32 s56, s28, 2
    s_lshr_b32 s57, s29, 3
    s_add_u32 s56, s56, s57
    s_lshl_b32 s56, s56, 9
    s_add_u32 s56, s56, 0x40000
    v_lshl_add_u32 v117, v2, 2, v6
    v_and_b32 v10, 4, v1
    v_lshl_add_u32 v117, v10, 2, v117
    v_lshl_add_u32 v117, v117, 4, s56
    s_branch L_sA
L_sB:
    s_mul_i32 s56, s45, 1152
    s_add_u32 s56, s56, 126400
    v_mul_u32_u24 v123, 144, v2
    v_lshl_add_u32 v123, v3, 3, v123
    v_add_u32 v123, s56, v123
L_sA:
    s_barrier
    ds_read_b128 v[68:71], v106
    ds_read_b128 v[72:75], v107
    ds_read_b128 v[76:79], v108
    ds_read_b128 v[80:83], v109
    s_mov_b32 s52, 0
    s_mov_b32 s42, s54
    s_waitcnt vmcnt(0)
L_pl_q:
    v_perm_b32 v10, v25, v24, s49
    v_perm_b32 v11, v27, v26, s50
    v_or_b32 v10, v10, v11
    v_cmp_ne_u32 vcc, s42, v10
    s_cbranch_vccnz L_pc_q
L_pd_q:
    s_mov_b64 exec, -1
    v_permlane32_swap_b32 v24, v26
    v_permlane32_swap_b32 v25, v27
    v_add_f32 v24, v24, v26
    v_add_f32 v25, v25, v27
    s_nop 1
    v_permlane16_swap_b32 v24, v25
    v_add_f32 v24, v24, v25
    v_cvt_pk_bf16_f32 v24, v24, v24
    ds_write_b16 v110, v24
    s_cmp_eq_u32 s36, 0
    s_waitcnt lgkmcnt(0)
    s_barrier
    ds_read_b128 v[52:55], v111 offset:0
    ds_read_b128 v[56:59], v111 offset:64
    ds_read_b128 v[60:63], v111 offset:128
    ds_read_b128 v[64:67], v111 offset:192
    s_cbranch_scc1 L_noh0
    global_load_dwordx4 v[28:31], v119, s[26:27] offset:0 sc1
    global_load_dwordx4 v[32:35], v120, s[26:27] offset:0 sc1
L_noh0:
    s_cmp_lg_u32 s3, 2
    s_cbranch_scc1 L_nowm
    global_load_dword v126, v126, s[26:27]
L_nowm:
    s_waitcnt lgkmcnt(3)
    v_mfma_f32_16x16x32_bf16 v[36:39], v[52:55], v[68:71], 0
    s_waitcnt lgkmcnt(2)
    v_mfma_f32_16x16x32_bf16 v[36:39], v[56:59], v[72:75], v[36:39]
    s_waitcnt lgkmcnt(1)
    v_mfma_f32_16x16x32_bf16 v[36:39], v[60:63], v[76:79], v[36:39]
    s_waitcnt lgkmcnt(0)
    v_mfma_f32_16x16x32_bf16 v[36:39], v[64:67], v[80:83], v[36:39]
    s_nop 7
    v_cvt_pk_bf16_f32 v22, 0, v36
    v_mul_f32 v22, s44, v22
    v_cvt_pk_bf16_f32 v22, 0, v22
    s_nop 1
    v_max_f32_dpp v21, v22, v22 quad_perm:[1,0,3,2] row_mask:0xf bank_mask:0xf
    s_nop 1
    v_max_f32_dpp v21, v21, v21 quad_perm:[2,3,0,1] row_mask:0xf bank_mask:0xf
    s_nop 1
    v_max_f32_dpp v21, v21, v21 row_half_mirror row_mask:0xf bank_mask:0xf
    s_nop 1
    v_max_f32_dpp v21, v21, v21 row_mirror row_mask:0xf bank_mask:0xf
    ds_write_b32 v112, v21
    s_waitcnt lgkmcnt(0)
    s_barrier
    ds_read_b128 v[52:55], v113
    ds_read_b128 v[56:59], v113 offset:16
    s_waitcnt lgkmcnt(0)
    v_max3_f32 v52, v52, v53, v54
    v_max3_f32 v55, v55, v56, v57
    v_max3_f32 v52, v52, v58, v59
    v_max_f32 v21, v52, v55
    v_sub_f32 v22, v22, v21
    v_mul_f32 v22, s55, v22
    v_exp_f32 v22, v22
    s_nop 0
    v_cvt_pk_bf16_f32 v22, v22, v22
    ds_write_b16 v114, v22
    s_waitcnt lgkmcnt(0)
    s_barrier
    ds_read_b128 v[52:55], v111 offset:1280
    ds_read_b128 v[56:59], v111 offset:1344
    ds_read_b128 v[60:63], v111 offset:1408
    ds_read_b128 v[64:67], v111 offset:1472
    s_cmp_lg_u32 s3, 4
    s_cbranch_scc1 L_nost
    s_and_b32 s56, s54, 0xff
    s_bfe_u32 s57, s54, 0x80008
    s_lshr_b32 s59, s54, 16
    v_or_b32 v28, s56, v21
    v_mov_b32 v30, s59
    v_lshrrev_b32 v31, 8, v30
    v_mov_b32 v8, s57
    s_waitcnt lgkmcnt(3)
    v_mfma_f32_16x16x32_bf16 v[40:43], v[52:55], v[48:51], 0
    s_waitcnt lgkmcnt(2)
    v_mfma_f32_16x16x32_bf16 v[40:43], v[56:59], v[48:51], v[40:43]
    s_waitcnt lgkmcnt(1)
    v_mfma_f32_16x16x32_bf16 v[40:43], v[60:63], v[48:51], v[40:43]
    s_waitcnt lgkmcnt(0)
    v_mfma_f32_16x16x32_bf16 v[40:43], v[64:67], v[48:51], v[40:43]
    s_mov_b32 exec_lo, 0x10001
    s_mov_b32 exec_hi, 0x10001
    s_nop 5
    v_and_or_b32 v29, v40, s51, v8
    global_store_dwordx4 v19, v[28:31], s[26:27]
    s_mov_b64 exec, -1
L_nost:
    s_barrier
    ds_read_b64_tr_b16 v[68:69], v115 offset:0
    ds_read_b64_tr_b16 v[70:71], v115 offset:1024
    ds_read_b64_tr_b16 v[72:73], v115 offset:8192
    ds_read_b64_tr_b16 v[74:75], v115 offset:9216
    ds_read_b64_tr_b16 v[76:77], v115 offset:16384
    ds_read_b64_tr_b16 v[78:79], v115 offset:17408
    ds_read_b64_tr_b16 v[80:81], v115 offset:24576
    ds_read_b64_tr_b16 v[82:83], v115 offset:25600
    s_waitcnt lgkmcnt(6)
    v_mfma_f32_16x16x32_bf16 v[36:39], v[52:55], v[68:71], 0
    s_waitcnt lgkmcnt(4)
    v_mfma_f32_16x16x32_bf16 v[36:39], v[56:59], v[72:75], v[36:39]
    s_waitcnt lgkmcnt(2)
    v_mfma_f32_16x16x32_bf16 v[36:39], v[60:63], v[76:79], v[36:39]
    s_waitcnt lgkmcnt(0)
    v_mfma_f32_16x16x32_bf16 v[36:39], v[64:67], v[80:83], v[36:39]
    s_nop 7
    v_and_or_b32 v36, v36, s51, v4
    global_store_dword v116, v36, s[26:27]
    s_cmp_ge_u32 s3, 4
    s_cbranch_scc1 L_wB
    s_cmp_eq_u32 s36, 0
    s_cbranch_scc1 L_noh1
    s_mov_b32 s52, 0
    s_mov_b32 s42, s54
    s_waitcnt vmcnt(1)
L_pl_h:
    v_perm_b32 v10, v29, v28, s49
    v_perm_b32 v11, v31, v30, s50
    v_perm_b32 v12, v33, v32, s49
    v_perm_b32 v13, v35, v34, s50
    v_bitop3_b32 v10, v10, v11, s42 bitop3:0x96
    v_bitop3_b32 v12, v12, v13, s42 bitop3:0x96
    v_or_b32 v10, v10, v12
    v_cmp_ne_u32 vcc, 0, v10
    s_cbranch_vccnz L_pc_h
L_pd_h:
    s_mov_b64 exec, -1
    v_pk_add_f32 v[28:29], v[28:29], v[32:33]
    v_pk_add_f32 v[30:31], v[30:31], v[34:35]
    s_nop 1
    v_permlane32_swap_b32 v28, v30
    v_permlane32_swap_b32 v29, v31
    v_add_f32 v28, v28, v30
    v_add_f32 v29, v29, v31
    s_nop 1
    v_permlane16_swap_b32 v28, v29
    v_add_f32 v28, v28, v29
    v_cvt_pk_bf16_f32 v28, 0, v28
    v_mul_f32 v11, s55, v28
    v_exp_f32 v11, -v11
    v_mov_b32_dpp v10, v28 row_ror:8 row_mask:0xf bank_mask:0xf
    v_add_f32 v11, 1.0, v11
    v_rcp_f32 v11, v11
    s_nop 0
    v_mul_f32 v11, v11, v28
    v_cvt_pk_bf16_f32 v11, 0, v11
    v_mul_f32 v11, v11, v10
    v_cvt_pk_bf16_f32 v11, v11, v11
    s_mov_b32 exec_lo, 0x00ff00ff
    s_mov_b32 exec_hi, 0x00ff00ff
    ds_write_b16 v14, v11
    s_mov_b64 exec, -1
    s_waitcnt lgkmcnt(0)
L_noh1:
    s_barrier
    global_load_dwordx4 v[28:31], v117, s[26:27] offset:0 sc1
    s_barrier
    ds_read_b64_tr_b16 v[68:69], v121 offset:0
    ds_read_b64_tr_b16 v[70:71], v121 offset:1024
    ds_read_b64_tr_b16 v[72:73], v121 offset:8192
    ds_read_b64_tr_b16 v[74:75], v121 offset:9216
    ds_read_b64_tr_b16 v[76:77], v122 offset:0
    ds_read_b64_tr_b16 v[78:79], v122 offset:1024
    ds_read_b64_tr_b16 v[80:81], v122 offset:8192
    ds_read_b64_tr_b16 v[82:83], v122 offset:9216
    s_mov_b32 s52, 0
    s_mov_b32 s42, s54
    s_waitcnt vmcnt(0)
L_pl_st:
    v_perm_b32 v10, v29, v28, s49
    v_perm_b32 v11, v31, v30, s50
    v_or_b32 v10, v10, v11
    v_cmp_ne_u32 vcc, s42, v10
    s_cbranch_vccz L_pd_st
    s_mov_b64 exec, vcc
    s_cmp_ge_u32 s52, 32
    s_cbranch_scc1 L_px_st
L_pr_st:
    global_load_dwordx4 v[28:31], v117, s[26:27] offset:0 sc1
    s_add_u32 s52, s52, 1
    s_waitcnt vmcnt(0)
    s_branch L_pl_st
L_pd_st:
    s_mov_b64 exec, -1
    v_and_b32 v28, s51, v28
    s_nop 1
    v_max_f32_dpp v21, v28, v28 quad_perm:[1,0,3,2] row_mask:0xf bank_mask:0xf
    s_nop 1
    v_max_f32_dpp v21, v21, v21 quad_perm:[2,3,0,1] row_mask:0xf bank_mask:0xf
    s_nop 1
    v_max_f32_dpp v21, v21, v21 row_half_mirror row_mask:0xf bank_mask:0xf
    v_mov_b32 v10, v21
    s_nop 1
    v_permlane16_swap_b32 v21, v10
    v_max_f32 v21, v21, v10
    v_mov_b32 v10, v21
    s_nop 1
    v_permlane32_swap_b32 v21, v10
    v_max_f32 v21, v21, v10
    v_sub_f32 v28, v28, v21
    v_mul_f32 v28, s55, v28
    v_exp_f32 v28, v28
    s_barrier
    ds_read_b128 v[52:55], v123 offset:0
    ds_read_b128 v[56:59], v123 offset:64
    ds_read_b128 v[60:63], v123 offset:2304
    ds_read_b128 v[64:67], v123 offset:2368
    v_mul_f32 v22, v28, v29
    v_mov_b32_dpp v84, v28 row_newbcast:0 row_mask:0xf bank_mask:0xf
    v_mov_b32_dpp v85, v28 row_newbcast:1 row_mask:0xf bank_mask:0xf
    v_add_f32_dpp v22, v22, v22 quad_perm:[1,0,3,2] row_mask:0xf bank_mask:0xf
    v_mov_b32_dpp v86, v28 row_newbcast:2 row_mask:0xf bank_mask:0xf
    v_mov_b32_dpp v87, v28 row_newbcast:3 row_mask:0xf bank_mask:0xf
    v_add_f32_dpp v22, v22, v22 quad_perm:[2,3,0,1] row_mask:0xf bank_mask:0xf
    v_mov_b32_dpp v88, v28 row_newbcast:4 row_mask:0xf bank_mask:0xf
    v_mov_b32_dpp v89, v28 row_newbcast:5 row_mask:0xf bank_mask:0xf
    v_add_f32_dpp v22, v22, v22 row_half_mirror row_mask:0xf bank_mask:0xf
    v_mov_b32 v10, v22
    v_mov_b32_dpp v90, v28 row_newbcast:6 row_mask:0xf bank_mask:0xf
    v_mov_b32_dpp v91, v28 row_newbcast:7 row_mask:0xf bank_mask:0xf
    v_permlane16_swap_b32 v22, v10
    v_add_f32 v22, v22, v10
    v_mov_b32 v10, v22
    s_waitcnt lgkmcnt(3)
    v_mfma_f32_16x16x32_bf16 v[36:39], v[52:55], v[68:71], 0
    v_permlane32_swap_b32 v22, v10
    v_mfma_f32_16x16x32_bf16 v[40:43], v[52:55], v[76:79], 0
    v_add_f32 v22, v22, v10
    s_waitcnt lgkmcnt(2)
    v_mfma_f32_16x16x32_bf16 v[36:39], v[56:59], v[72:75], v[36:39]
    v_rcp_f32 v22, v22
    v_mfma_f32_16x16x32_bf16 v[40:43], v[56:59], v[80:83], v[40:43]
    s_waitcnt lgkmcnt(1)
    v_mfma_f32_16x16x32_bf16 v[44:47], v[60:63], v[68:71], 0
    v_mfma_f32_16x16x32_bf16 v[48:51], v[60:63], v[76:79], 0
    s_waitcnt lgkmcnt(0)
    v_mfma_f32_16x16x32_bf16 v[44:47], v[64:67], v[72:75], v[44:47]
    v_mfma_f32_16x16x32_bf16 v[48:51], v[64:67], v[80:83], v[48:51]
    v_pk_mul_f32 v[24:25], v[36:37], v[84:85]
    s_nop 0
    v_pk_mul_f32 v[26:27], v[40:41], v[84:85]
    v_pk_fma_f32 v[24:25], v[38:39], v[86:87], v[24:25]
    v_pk_fma_f32 v[26:27], v[42:43], v[86:87], v[26:27]
    s_nop 1
    v_pk_fma_f32 v[24:25], v[44:45], v[88:89], v[24:25]
    v_pk_fma_f32 v[26:27], v[48:49], v[88:89], v[26:27]
    v_pk_fma_f32 v[24:25], v[46:47], v[90:91], v[24:25]
    v_pk_fma_f32 v[26:27], v[50:51], v[90:91], v[26:27]
    v_add_f32 v6, v24, v25
    v_add_f32 v7, v26, v27
    s_nop 1
    v_permlane16_swap_b32 v6, v7
    v_add_f32 v8, v6, v7
    v_add_f32 v9, v6, v7
    s_nop 1
    v_permlane32_swap_b32 v8, v9
    v_add_f32 v6, v8, v9
    v_mul_f32 v6, v6, v22
    s_mov_b32 exec_hi, 0
    v_and_or_b32 v6, v6, s51, v5
    global_store_dword v124, v6, s[26:27] sc1
    s_branch L_nos
L_wB:
    s_setprio 2
    s_cmp_eq_u32 s28, 0
    s_barrier
    global_load_dwordx4 v[24:27], v117, s[26:27] offset:0 sc1
    global_load_dwordx4 v[32:35], v118, s[26:27] offset:0 sc1
    s_cbranch_scc1 L_noy
    ds_read_b128 v[52:55], v15
    ds_read_b64_tr_b16 v[68:69], v121 offset:0
    ds_read_b64_tr_b16 v[70:71], v121 offset:1024
    ds_read_b64_tr_b16 v[72:73], v122 offset:0
    ds_read_b64_tr_b16 v[74:75], v122 offset:1024
    s_waitcnt lgkmcnt(2)
    v_mfma_f32_16x16x32_bf16 v[36:39], v[52:55], v[68:71], 0
    s_waitcnt lgkmcnt(0)
    v_mfma_f32_16x16x32_bf16 v[40:43], v[52:55], v[72:75], 0
    s_mov_b32 vcc_lo, 0xffff0000
    s_nop 6
    v_cndmask_b32 v36, v36, v40, vcc
    v_and_or_b32 v36, v36, s51, v5
L_noy:
    v_writelane_b32 v36, s48, 32
    s_cselect_b32 s33, 0, -1
    s_barrier
    s_mov_b32 s52, 0
    s_mov_b32 s42, s54
    s_waitcnt vmcnt(0)
L_pl_o:
    v_cvt_pk_bf16_f32 v84, v24, v25
    v_cvt_pk_bf16_f32 v85, v26, v27
    v_cvt_pk_bf16_f32 v86, v32, v33
    v_cvt_pk_bf16_f32 v87, v34, v35
    ds_write2_b64 v123, v[84:85], v[86:87] offset0:0 offset1:72
    v_perm_b32 v10, v25, v24, s49
    v_perm_b32 v11, v27, v26, s50
    v_perm_b32 v12, v33, v32, s49
    v_perm_b32 v13, v35, v34, s50
    v_bitop3_b32 v10, v10, v11, s42 bitop3:0x96
    v_bitop3_b32 v12, v12, v13, s42 bitop3:0x96
    v_or_b32 v10, v10, v12
    v_cmp_ne_u32 vcc, 0, v10
    s_cbranch_vccz L_pd_o
    s_mov_b64 exec, vcc
    s_cmp_ge_u32 s52, 32
    s_cbranch_scc1 L_px_o
L_pr_o:
    global_load_dwordx4 v[24:27], v117, s[26:27] offset:0 sc1
    global_load_dwordx4 v[32:35], v118, s[26:27] offset:0 sc1
    s_add_u32 s52, s52, 1
    s_waitcnt vmcnt(0)
    s_branch L_pl_o
L_pd_o:
    s_mov_b64 exec, -1
    s_mov_b32 exec_lo, s33
    s_mov_b32 exec_hi, 1
    s_waitcnt lgkmcnt(0)
    s_barrier
    global_store_dword v124, v36, s[26:27] sc1
L_nos:
    s_cmp_ge_u32 s53, 16
    s_cbranch_scc1 L_fin
    s_mov_b64 exec, -1
    s_mov_b32 s6, s48
    s_mov_b32 s7, s48
    s_mov_b32 s52, 0
    s_cmp_eq_u32 s3, 0
    s_cselect_b32 s56, 0, 0x40000
    s_cselect_b32 s33, 0, -1
    v_add_u32 v118, s56, v125
    s_waitcnt vmcnt(0)
    s_load_dwordx8 s[8:15], s[34:35], 0 glc
    global_load_ushort v23, v18, s[4:5] sc1
    s_waitcnt vmcnt(0)
    v_lshlrev_b32 v23, 16, v23
L_sn:
    s_load_dwordx8 s[8:15], s[34:35], 0 glc
    s_add_u32 s52, s52, 1
    s_cmp_gt_u32 s52, 0x40000
    s_cbranch_scc1 L_snx
    s_waitcnt lgkmcnt(2)
    s_cmp_lg_u64 s[8:9], s[6:7]
    s_cbranch_scc1 L_sn
    s_cmp_lg_u64 s[10:11], s[6:7]
    s_cbranch_scc1 L_sn
    s_cmp_lg_u64 s[12:13], s[6:7]
    s_cbranch_scc1 L_sn
    s_cmp_lg_u64 s[14:15], s[6:7]
    s_cbranch_scc1 L_sn
L_snx:
    global_load_dwordx4 v[24:27], v125, s[26:27] offset:0 sc1
    global_load_dwordx4 v[32:35], v118, s[26:27] offset:0 sc1
    s_mov_b32 s52, 0
    s_waitcnt vmcnt(0)
L_pl_gs:
    v_perm_b32 v10, v25, v24, s49
    v_perm_b32 v11, v27, v26, s50
    v_perm_b32 v12, v33, v32, s49
    v_perm_b32 v13, v35, v34, s50
    v_bitop3_b32 v10, v10, v11, s48 bitop3:0x96
    v_bitop3_b32 v12, v12, v13, s48 bitop3:0x96
    v_or_b32 v10, v10, v12
    v_cmp_ne_u32 vcc, 0, v10
    s_cbranch_vccz L_pd_gs
    s_mov_b64 exec, vcc
    s_cmp_ge_u32 s52, 262144
    s_cbranch_scc1 L_px_gs
L_pr_gs:
    global_load_dwordx4 v[24:27], v125, s[26:27] offset:0 sc1
    global_load_dwordx4 v[32:35], v118, s[26:27] offset:0 sc1
    s_add_u32 s52, s52, 1
    s_waitcnt vmcnt(0)
    s_branch L_pl_gs
L_pd_gs:
    s_mov_b64 exec, -1
    v_permlane32_swap_b32 v24, v26
    v_permlane32_swap_b32 v25, v27
    v_permlane32_swap_b32 v32, v34
    v_permlane32_swap_b32 v33, v35
    v_pk_add_f32 v[24:25], v[24:25], v[26:27]
    v_pk_add_f32 v[32:33], v[32:33], v[34:35]
    s_nop 0
    v_permlane16_swap_b32 v24, v25
    v_permlane16_swap_b32 v32, v33
    v_add_f32 v24, v24, v25
    v_add_f32 v32, v32, v33
    s_nop 0
    v_add_f32_dpp v24, v24, v24 row_ror:8 row_mask:0xf bank_mask:0xf
    v_add_f32_dpp v32, v32, v32 row_ror:8 row_mask:0xf bank_mask:0xf
    v_and_b32 v32, s33, v32
    ds_write2st64_b32 v16, v24, v32 offset0:0 offset1:6
    s_cmp_lg_u32 s3, 0
    s_waitcnt lgkmcnt(0)
    s_barrier
    s_cbranch_scc1 L_ep
    ds_read_b128 v[52:55], v17
    ds_read_b128 v[56:59], v17 offset:16
    s_waitcnt lgkmcnt(1)
    v_pk_add_f32 v[52:53], v[52:53], v[54:55]
    s_waitcnt lgkmcnt(0)
    v_pk_add_f32 v[56:57], v[56:57], v[58:59]
    v_pk_add_f32 v[52:53], v[52:53], v[56:57]
    v_add_f32 v52, v52, v53
    v_cvt_pk_bf16_f32 v52, 0, v52
    v_mul_f32 v11, s55, v52
    v_exp_f32 v11, -v11
    v_mov_b32 v6, v52
    v_add_f32 v11, 1.0, v11
    v_rcp_f32 v11, v11
    v_permlane32_swap_b32 v7, v6
    v_mul_f32 v11, v11, v52
    v_cvt_pk_bf16_f32 v11, 0, v11
    v_mul_f32 v11, v11, v7
    v_cvt_pk_bf16_f32 v11, 0, v11
    s_mov_b32 exec_lo, 0
    v_add_f32 v11, v11, v23
    v_cvt_pk_bf16_f32 v11, v11, v11
    global_store_short v18, v11, s[22:23]
    s_endpgm
L_ep:
    s_lshl_b32 s56, s53, 3
    s_add_u32 s56, s56, s3
    s_cmp_lg_u32 s56, 1
    s_cbranch_scc1 L_fin
    v_mov_b32 v6, 0
    v_mov_b32 v7, s48
    global_store_dword v6, v7, s[26:27]
L_fin:
L_end:
    s_endpgm
L_flush:
    s_mov_b64 s[38:39], exec
    s_mov_b64 exec, -1
    s_add_u32 s46, s26, 0x100000
    s_addc_u32 s47, s27, 0
    v_lshl_add_u32 v104, v1, 4, s60
    v_lshl_add_u32 v105, v1, 4, s62
    s_mov_b32 exec_lo, 0
    v_lshl_add_u32 v105, v3, 4, s61
    s_mov_b32 exec_hi, 0xffff0000
    v_and_b32 v105, 3, v1
    v_lshl_add_u32 v105, v105, 9, s63
    s_mov_b64 exec, -1
    global_load_dwordx4 v[92:95], v104, s[26:27] offset:0 sc1
    global_load_dwordx4 v[96:99], v104, s[26:27] offset:1024 sc1
    global_load_dwordx4 v[100:103], v105, s[26:27] offset:0 sc1
    s_waitcnt vmcnt(0)
    v_xor_b32 v92, s43, v92
    v_xor_b32 v96, s43, v96
    v_xor_b32 v100, s43, v100
    global_store_dwordx4 v104, v[92:95], s[46:47] sc1
    global_store_dwordx4 v104, v[96:99], s[46:47] offset:1024 sc1
    global_store_dwordx4 v105, v[100:103], s[46:47] sc1
    s_waitcnt vmcnt(0)
    s_mov_b64 exec, s[38:39]
    s_setpc_b64 s[40:41]
L_pc_q:
    s_mov_b64 exec, vcc
    s_cmp_ge_u32 s52, 32
    s_cbranch_scc1 L_px_q
L_pr_q:
    global_load_dwordx4 v[24:27], v20, s[26:27] offset:0 sc1
    s_add_u32 s52, s52, 1
    s_waitcnt vmcnt(0)
    s_branch L_pl_q
L_px_q:
    s_cmp_gt_u32 s52, 0x40000
    s_cbranch_scc1 L_pd_q
    v_xor_b32 v20, 0x100000, v20
    s_xor_b32 s42, s42, s43
    s_cmp_lg_u32 s52, 32
    s_cbranch_scc1 L_pr_q
    s_call_b64 s[40:41], L_flush
    s_branch L_pr_q
L_pc_h:
    s_mov_b64 exec, vcc
    s_cmp_ge_u32 s52, 32
    s_cbranch_scc1 L_px_h
L_pr_h:
    global_load_dwordx4 v[28:31], v119, s[26:27] offset:0 sc1
    global_load_dwordx4 v[32:35], v120, s[26:27] offset:0 sc1
    s_add_u32 s52, s52, 1
    s_waitcnt vmcnt(0)
    s_branch L_pl_h
L_px_h:
    s_cmp_gt_u32 s52, 0x40000
    s_cbranch_scc1 L_pd_h
    v_xor_b32 v119, 0x100000, v119
    v_xor_b32 v120, 0x100000, v120
    s_xor_b32 s42, s42, s43
    s_cmp_lg_u32 s52, 32
    s_cbranch_scc1 L_pr_h
    s_call_b64 s[40:41], L_flush
    s_branch L_pr_h
L_px_st:
    s_cmp_gt_u32 s52, 0x40000
    s_cbranch_scc1 L_pd_st
    v_xor_b32 v117, 0x100000, v117
    s_xor_b32 s42, s42, s43
    s_cmp_lg_u32 s52, 32
    s_cbranch_scc1 L_pr_st
    s_call_b64 s[40:41], L_flush
    s_branch L_pr_st
L_px_o:
    s_cmp_gt_u32 s52, 0x40000
    s_cbranch_scc1 L_pd_o
    v_xor_b32 v117, 0x100000, v117
    v_xor_b32 v118, 0x100000, v118
    s_xor_b32 s42, s42, s43
    s_cmp_lg_u32 s52, 32
    s_cbranch_scc1 L_pr_o
    s_call_b64 s[40:41], L_flush
    s_branch L_pr_o
L_px_gs:
    s_branch L_pd_gs
L_codeend:

.section .rodata,"a"
.p2align 6
.amdhsa_kernel recurrent_scan__sliding_block_cached__swiglu_ffn__decode_kernel
  .amdhsa_next_free_vgpr 128
  .amdhsa_next_free_sgpr 64
  .amdhsa_accum_offset 128
  .amdhsa_group_segment_fixed_size 0
  .amdhsa_kernarg_size 96
  .amdhsa_user_sgpr_count 2
  .amdhsa_user_sgpr_kernarg_segment_ptr 1
  .amdhsa_system_sgpr_workgroup_id_x 1
  .amdhsa_float_denorm_mode_32 3
.end_amdhsa_kernel
```
